```python
import torch

def _softmax(x, axis=-1):
    return torch.softmax(x, dim=axis)
def _gelu(x):
    return torch.nn.functional.gelu(x, approximate="tanh")
def _silu(x):
    return torch.nn.functional.silu(x)
def _sigmoid(x):
    return torch.sigmoid(x)
def _layernorm(x, axis=-1, eps=1e-5):
    m = x.mean(dim=axis, keepdim=True)
    v = x.var(dim=axis, keepdim=True, unbiased=False)
    return (x - m) / torch.sqrt(v + eps)
def _scatter_add(tgt, idx, src, axis=0):
    return tgt.clone().index_add_(axis, idx, src)
def _segment_sum(src, seg, n):
    out = torch.zeros((n,) + src.shape[1:], dtype=src.dtype)
    return out.index_add_(0, seg, src)
def _pad(x, pw):
    flat = tuple(v for pair in reversed(pw) for v in pair)
    return torch.nn.functional.pad(x, flat)

kernel_name = 'recurrent_scan__sliding_block_cached__swiglu_ffn__decode'

def setup_inputs():

    _w = (lambda a: (lambda t: t.to(torch.bfloat16) if t.is_floating_point() else t)(torch.as_tensor(a)))
    def _A_setup():
        B, Sq, D = 1, 1, 512
        Hq, Hkv, Sk, Dh = 32, 8, 16384, 128
        assert Hq % Hkv == 0, (Hq, Hkv)
        return {
            "x": _w((lambda *s: torch.randn(*s, dtype=torch.bfloat16) * 0.05)(B, Sq, D)),
            "k_cache": _w((lambda *s: torch.randn(*s, dtype=torch.bfloat16) * 1.6)(B, Hkv, Sk, Dh)),
            "v_cache": _w((lambda *s: torch.randn(*s, dtype=torch.bfloat16) * 0.2)(B, Hkv, Sk, Dh)),
            "wq": _w((lambda *s: torch.randn(*s, dtype=torch.bfloat16) * 1.6)(D, Hq * Dh) * (D ** -0.5)),
            "wo": _w((lambda *s: torch.randn(*s, dtype=torch.bfloat16) * 0.2)(Hq * Dh, D) * ((Hq * Dh) ** -0.5)),
        }
    _A_in = _A_setup()

    def _B_setup():
        B, S, D, F = 1, 1, 512, 1792
        return {
            "x": _w((lambda *s: torch.randn(*s, dtype=torch.bfloat16) * 0.05)(B, S, D)),
            "w_gate": _w((lambda *s: torch.randn(*s, dtype=torch.bfloat16) * 0.1)(D, F)),
            "w_up": _w((lambda *s: torch.randn(*s, dtype=torch.bfloat16) * 0.1)(D, F)),
            "w_down": _w((lambda *s: torch.randn(*s, dtype=torch.bfloat16) * 0.1)(F, D)),
        }
    _B_in = _B_setup()

    return {
        "A_x": _A_in["x"],
        "A_k_cache": _A_in["k_cache"],
        "A_v_cache": _A_in["v_cache"],
        "A_wq": _A_in["wq"],
        "A_wo": _A_in["wo"],
        "B_x": _B_in["x"],
        "B_w_gate": _B_in["w_gate"],
        "B_w_up": _B_in["w_up"],
        "B_w_down": _B_in["w_down"],
    }

def reference(A_x, A_k_cache, A_v_cache, A_wq, A_wo, B_x, B_w_gate, B_w_up, B_w_down):
    def _A_ref(x, k_cache, v_cache, wq, wo):
        B, Sq, D = x.shape
        Hq, Dh = 32, 128
        Hkv, Sk = k_cache.shape[1], k_cache.shape[2]
        W = min(4096, max(256, Sk // 4))
        rep = Hq // Hkv
        q = (lambda x, *d: x.permute(*d))((x @ wq).reshape(B, Sq, Hq, Dh), 0, 2, 1, 3)
        k = (lambda x, n, axis: torch.repeat_interleave(x, n, dim=axis))(k_cache[:, :, Sk - W:, :], rep, axis=1)
        v = (lambda x, n, axis: torch.repeat_interleave(x, n, dim=axis))(v_cache[:, :, Sk - W:, :], rep, axis=1)
        scores = torch.einsum("bhqd,bhkd->bhqk", q, k) * (Dh ** -0.5)
        p = _softmax(scores, axis=-1)
        o = torch.einsum("bhqk,bhkd->bhqd", p, v)
        return (lambda x, *d: x.permute(*d))(o, 0, 2, 1, 3).reshape(B, Sq, Hq * Dh) @ wo

    def _B_ref(x, w_gate, w_up, w_down):
        g = _silu(x @ w_gate)
        u = x @ w_up
        return (g * u) @ w_down

    x = A_x
    xn = _layernorm(x, axis=-1)
    s = _A_ref(xn, A_k_cache, A_v_cache, A_wq, A_wo)
    g = _silu(_B_ref(xn, B_w_gate, B_w_up, B_w_down))
    return x + s * g
```

```asm
; @launch grid=(256,1,1) block=(320,1,1) lds=131072
.amdgcn_target "amdgcn-amd-amdhsa--gfx950"
.text
.globl recurrent_scan__sliding_block_cached__swiglu_ffn__decode_kernel
.p2align 12
.p2align 8
.type recurrent_scan__sliding_block_cached__swiglu_ffn__decode_kernel,@function
recurrent_scan__sliding_block_cached__swiglu_ffn__decode_kernel:
    s_cmp_ge_u32 s2, 256
    s_cbranch_scc1 L_end
    s_load_dwordx16 s[4:19], s[0:1], 0
    s_load_dwordx8 s[20:27], s[0:1], 64
    v_lshrrev_b32 v122, 6, v0
    v_and_b32 v1, 63, v0
    s_and_b32 s28, s2, 7
    v_readfirstlane_b32 s3, v122
    s_lshr_b32 s29, s2, 3
    s_lshr_b32 s30, s2, 6
    s_and_b32 s31, s29, 7
    s_lshr_b32 s32, s31, 1
    s_lshl3_add_u32 s34, s32, s28
    s_cmp_lt_u32 s34, 28
    s_cselect_b32 s63, 0, 2097152
    s_cselect_b32 s59, 0, 8
    s_sub_u32 s34, s34, s59
    s_and_b32 s33, s31, 1
    s_mov_b32 s47, s31
    s_cmp_ge_u32 s28, 4
    s_cselect_b32 s59, 5, 0
    s_xor_b32 s31, s31, s59
    v_lshrrev_b32 v6, 4, v1
    v_and_b32 v4, 15, v1
    v_mov_b32 v7, 0
    s_lshl2_add_u32 s54, s28, s30
    s_lshl1_add_u32 s60, s30, s33
    s_cmp_lg_u32 s3, 0
    s_cbranch_scc1 L_comp
    s_setprio 3
    v_lshrrev_b32 v122, 5, v1
    v_bfe_u32 v123, v1, 3, 2
    v_lshl_add_u32 v2, v122, 3, v123
    v_lshlrev_b32 v124, 1, v6
    v_and_b32 v125, 7, v1
    v_xor_b32 v125, v125, v124
    v_lshlrev_b32 v3, 4, v125
    s_lshl_b32 s48, s30, 20
    s_lshl3_add_u32 s50, s28, s31
    s_lshl_b32 s50, s50, 7
    s_add_u32 s48, s48, s50
    v_lshl_add_u32 v16, v2, 13, v3
    v_add_u32 v16, s48, v16
    v_add_u32 v17, 130048, v16
    v_add_u32 v18, 30720, v16
    v_add_u32 v19, 160768, v16
    s_mul_i32 s49, s30, 458752
    s_lshl_b32 s50, s34, 7
    s_add_u32 s49, s49, s50
    v_mul_u32_u24 v20, 3584, v2
    v_add3_u32 v20, v20, v3, s49
    v_add_u32 v21, 56320, v20
    v_add_u32 v22, 12288, v20
    v_add_u32 v23, 68608, v20
    s_mov_b32 m0, 5120
    v_mov_b32 v199, 1
    v_lshlrev_b32 v5, 4, v1
    s_cmp_lg_u32 s33, 0
    s_waitcnt lgkmcnt(0)
    global_load_lds_dwordx4 v5, s[4:5] sc1
    s_mov_b32 m0, 8192
    s_cselect_b64 s[52:53], s[18:19], s[16:17]
    s_mov_b32 s100, 114688
    s_mov_b32 s101, 32768
    v_mov_b32 v40, 0
L_ld0:
    v_add_u32 v40, 1, v40
    s_waitcnt vmcnt(24)
    ds_write_b32 v7, v40 offset:3596
    global_load_lds_dwordx4 v16, s[10:11] offset:0 nt
    global_load_lds_dwordx4 v17, s[10:11] offset:1024 nt
    global_load_lds_dwordx4 v18, s[10:11] offset:2048 nt
    global_load_lds_dwordx4 v19, s[10:11] offset:3072 nt
    s_add_u32 s10, s10, 262144
    s_addc_u32 s11, s11, 0
    s_add_u32 m0, m0, 0x1000
    s_cmp_lg_u32 m0, 24576
    s_cbranch_scc1 L_ld0
    s_cmp_lg_u32 s63, 0
    s_cselect_b64 exec, 1, -1
L_ld1:
    v_add_u32 v40, 1, v40
    s_waitcnt vmcnt(24)
    ds_write_b32 v7, v40 offset:3596
    global_load_lds_dwordx4 v20, s[52:53] offset:0 nt
    global_load_lds_dwordx4 v21, s[52:53] offset:1024 nt
    global_load_lds_dwordx4 v22, s[52:53] offset:2048 nt
    global_load_lds_dwordx4 v23, s[52:53] offset:3072 nt
    s_add_u32 s52, s52, s100
    s_addc_u32 s53, s53, 0
    s_add_u32 m0, m0, 0x1000
    s_cmp_lg_u32 m0, 32768
    s_cbranch_scc1 L_ld1
    s_mov_b64 exec, -1
    v_mov_b32 v40, 6
    s_waitcnt lgkmcnt(0)
    s_barrier
    s_load_dword s36, s[26:27], 0
    s_lshl3_add_u32 s48, s54, s31
    s_lshl_b32 s48, s48, 8
    s_lshl3_add_u32 s49, s54, s47
    s_lshl_b32 s49, s49, 8
    s_load_dword s96, s[26:27], s48 offset:65536
    s_load_dword s96, s[26:27], s48 offset:65600
    s_load_dword s96, s[26:27], s48 offset:65664
    s_load_dword s96, s[26:27], s48 offset:65728
    s_load_dword s97, s[26:27], s49 offset:131072
    s_load_dword s97, s[26:27], s49 offset:131136
    s_load_dword s97, s[26:27], s49 offset:131200
    s_load_dword s97, s[26:27], s49 offset:131264
    s_lshl_b32 s61, s28, 22
    s_lshl_b32 s50, s29, 15
    s_add_u32 s61, s61, s50
    s_add_u32 s61, s61, 0x300000
    v_xor_b32 v122, v4, v6
    v_lshlrev_b32 v122, 4, v122
    v_lshl_add_u32 v24, v6, 8, v122
    v_add_u32 v24, s61, v24
    v_xor_b32 v25, 64, v24
    v_xor_b32 v26, 0x80, v24
    v_xor_b32 v27, 0xc0, v24
    v_xor_b32 v122, v4, v124
    v_lshlrev_b32 v122, 4, v122
    v_lshl_add_u32 v28, v6, 8, v122
    v_add_u32 v28, s61, v28
    v_xor_b32 v29, 0x80, v28
    s_lshl_b32 s48, s54, 17
    s_lshl_b32 s49, s31, 7
    s_add_u32 s48, s48, s49
    v_lshl_add_u32 v122, v2, 10, v3
    v_add_u32 v32, s48, v122
    s_lshl_b32 s48, s34, 16
    s_lshl_b32 s49, s60, 7
    s_add_u32 s48, s48, s49
    v_add_u32 v36, s48, v122
    v_add_u32 v33, 15360, v32
    v_add_u32 v34, 2048, v32
    v_add_u32 v35, 17408, v32
    v_add_u32 v37, 15360, v36
    v_add_u32 v38, 2048, v36
    v_add_u32 v39, 17408, v36
    s_lshl_b32 s48, s28, 13
    s_add_u32 s48, s48, 65536
    s_lshl_b32 s49, s32, 9
    s_add_u32 s49, s49, 65536
    s_cmp_lg_u32 s63, 0
    s_cselect_b32 s49, 0, s49
    s_add_u32 s49, s49, s48
    v_and_b32 v121, 31, v1
    v_lshrrev_b32 v123, 5, v1
    v_lshlrev_b32 v124, 12, v123
    v_lshl_add_u32 v124, v121, 4, v124
    v_add_u32 v191, s49, v124
    v_lshlrev_b32 v123, 2, v123
    v_lshl_add_u32 v196, v121, 3, v123
    s_mov_b32 s57, 1069066811
    s_lshl_b32 s48, s31, 8
    s_add_u32 s48, s48, s54
    s_lshl_b32 s48, s48, 6
    s_add_u32 s98, s48, 262144
    s_lshl_b32 s48, s60, 8
    s_add_u32 s48, s48, s34
    s_lshl_b32 s48, s48, 6
    s_add_u32 s48, s48, s63
    s_add_u32 s99, s48, 264192
    s_cmp_lg_u32 s63, 0
    s_cselect_b64 exec, 1, -1
L_ld2:
    v_add_u32 v40, 1, v40
    s_waitcnt vmcnt(24)
    ds_write_b32 v7, v40 offset:3596
    global_load_lds_dwordx4 v20, s[52:53] offset:0 nt
    global_load_lds_dwordx4 v21, s[52:53] offset:1024 nt
    global_load_lds_dwordx4 v22, s[52:53] offset:2048 nt
    global_load_lds_dwordx4 v23, s[52:53] offset:3072 nt
    s_add_u32 s52, s52, s100
    s_addc_u32 s53, s53, 0
    s_add_u32 m0, m0, 0x1000
    s_cmp_lg_u32 m0, 40960
    s_cbranch_scc1 L_ld2
    s_mov_b64 exec, -1
    v_mov_b32 v40, 8
    s_load_dword s96, s[26:27], s98 offset:0
    s_load_dword s97, s[26:27], s99 offset:0
    s_load_dword s96, s[26:27], s98 offset:4096
    s_load_dword s97, s[26:27], s99 offset:4096
    s_load_dword s96, s[26:27], s98 offset:8192
    s_load_dword s97, s[26:27], s99 offset:8192
    s_load_dword s96, s[26:27], s98 offset:12288
    s_load_dword s97, s[26:27], s99 offset:12288
L_ld3:
    v_add_u32 v40, 1, v40
    s_waitcnt vmcnt(16)
    ds_write_b32 v7, v40 offset:3596
    global_load_lds_dwordx4 v24, s[6:7] offset:0 nt
    global_load_lds_dwordx4 v25, s[6:7] offset:1024 nt
    global_load_lds_dwordx4 v26, s[6:7] offset:2048 nt
    global_load_lds_dwordx4 v27, s[6:7] offset:3072 nt
    s_add_u32 s6, s6, 4096
    s_addc_u32 s7, s7, 0
    s_add_u32 m0, m0, 0x1000
    s_cmp_lg_u32 m0, 57344
    s_cbranch_scc1 L_ld3
L_ld4:
    v_add_u32 v40, 1, v40
    s_waitcnt vmcnt(20)
    ds_write_b32 v7, v40 offset:3596
    global_load_lds_dwordx4 v24, s[6:7] offset:0 nt
    global_load_lds_dwordx4 v25, s[6:7] offset:1024 nt
    global_load_lds_dwordx4 v26, s[6:7] offset:2048 nt
    global_load_lds_dwordx4 v27, s[6:7] offset:3072 nt
    s_add_u32 s6, s6, 4096
    s_addc_u32 s7, s7, 0
    s_add_u32 m0, m0, 0x1000
    s_cmp_lg_u32 m0, 73728
    s_cbranch_scc1 L_ld4
    s_cmp_lg_u32 s63, 0
    s_cselect_b64 exec, 1, -1
L_ld5:
    v_add_u32 v40, 1, v40
    s_waitcnt vmcnt(20)
    ds_write_b32 v7, v40 offset:3596
    global_load_lds_dwordx4 v36, s[20:21] offset:0 nt
    global_load_lds_dwordx4 v37, s[20:21] offset:1024 nt
    global_load_lds_dwordx4 v38, s[20:21] offset:2048 nt
    global_load_lds_dwordx4 v39, s[20:21] offset:3072 nt
    s_add_u32 s20, s20, s101
    s_addc_u32 s21, s21, 0
    s_add_u32 m0, m0, 0x1000
    s_cmp_lg_u32 m0, 81920
    s_cbranch_scc1 L_ld5
    s_mov_b64 exec, -1
    v_mov_b32 v40, 18
L_ld6:
    v_add_u32 v40, 1, v40
    s_waitcnt vmcnt(20)
    ds_write_b32 v7, v40 offset:3596
    global_load_lds_dwordx4 v28, s[8:9] offset:0 nt
    global_load_lds_dwordx4 v29, s[8:9] offset:1024 nt
    global_load_lds_dwordx4 v28, s[8:9] offset:2048 nt
    global_load_lds_dwordx4 v29, s[8:9] offset:3072 nt
    s_add_u32 s8, s8, 4096
    s_addc_u32 s9, s9, 0
    s_add_u32 m0, m0, 0x1000
    s_cmp_lg_u32 m0, 90112
    s_cbranch_scc1 L_ld6
    v_add_u32 v40, 1, v40
    s_waitcnt vmcnt(20)
    ds_write_b32 v7, v40 offset:3596
    s_mov_b32 exec_hi, 0
    global_load_dwordx4 v[200:203], v191, s[26:27] sc1
    global_load_dwordx4 v[204:207], v191, s[26:27] offset:2048 sc1
    s_not_b64 exec, exec
    global_load_dwordx4 v[200:203], v191, s[26:27] sc1
    global_load_dwordx4 v[204:207], v191, s[26:27] offset:2048 sc1
    s_mov_b64 exec, -1
L_ld8:
    v_add_u32 v40, 1, v40
    s_waitcnt vmcnt(20)
    ds_write_b32 v7, v40 offset:3596
    global_load_lds_dwordx4 v28, s[8:9] offset:0 nt
    global_load_lds_dwordx4 v29, s[8:9] offset:1024 nt
    global_load_lds_dwordx4 v28, s[8:9] offset:2048 nt
    global_load_lds_dwordx4 v29, s[8:9] offset:3072 nt
    s_add_u32 s8, s8, 4096
    s_addc_u32 s9, s9, 0
    s_add_u32 m0, m0, 0x1000
    s_cmp_lg_u32 m0, 110592
    s_cbranch_scc1 L_ld8
L_ld9:
    v_add_u32 v40, 1, v40
    global_load_lds_dwordx4 v28, s[8:9] offset:0 nt
    global_load_lds_dwordx4 v29, s[8:9] offset:1024 nt
    global_load_lds_dwordx4 v28, s[8:9] offset:2048 nt
    global_load_lds_dwordx4 v29, s[8:9] offset:3072 nt
    s_add_u32 s8, s8, 4096
    s_addc_u32 s9, s9, 0
    s_add_u32 m0, m0, 0x1000
    s_waitcnt vmcnt(24)
    ds_write_b32 v7, v40 offset:3596
    s_branch L_hb0
L_hb1:
L_ld10:
    v_add_u32 v40, 1, v40
    s_waitcnt vmcnt(20)
    ds_write_b32 v7, v40 offset:3596
    global_load_lds_dwordx4 v32, s[12:13] offset:0 nt
    global_load_lds_dwordx4 v33, s[12:13] offset:1024 nt
    global_load_lds_dwordx4 v34, s[12:13] offset:2048 nt
    global_load_lds_dwordx4 v35, s[12:13] offset:3072 nt
    s_add_u32 s12, s12, 32768
    s_addc_u32 s13, s13, 0
    s_add_u32 m0, m0, 0x1000
    s_cmp_lg_u32 m0, 131072
    s_cbranch_scc1 L_ld10
    s_waitcnt vmcnt(16)
    v_mov_b32 v40, 33
    ds_write_b32 v7, v40 offset:3596
    s_barrier
    s_cmp_lg_u32 s35, 0
    s_cbranch_scc1 L_lh2
L_lh2r:
    s_waitcnt vmcnt(8)
    v_mov_b32 v40, 35
    ds_write_b32 v7, v40 offset:3596
    s_waitcnt vmcnt(0)
    s_barrier
    s_cmp_ge_u32 s2, 32
    s_cbranch_scc1 L_fin
    s_branch L_red
L_comp:
    s_sub_u32 s3, s3, 1
    v_lshlrev_b32 v5, 4, v1
    v_lshlrev_b32 v122, 2, v1
    s_mov_b32 exec_lo, 0xfffffff7
    s_mov_b32 exec_hi, 0
    ds_write_b32 v122, v7 offset:3584
    s_mov_b64 exec, -1
    s_waitcnt lgkmcnt(0)
    s_load_dword s36, s[26:27], 0
    s_getpc_b64 s[48:49]
L_pc:
    s_and_b32 s50, s2, 0xf8
    s_lshl_b32 s50, s50, 4
    s_load_dword s96, s[48:49], s50
    s_add_u32 s50, s50, L_p2-L_pc
    s_load_dword s97, s[48:49], s50
    s_load_dword s96, s[48:49], s50 offset:4096
    s_barrier
    s_lshl_b32 s62, s3, 13
    s_lshl3_add_u32 s48, s54, s31
    s_lshl2_add_u32 s48, s48, s3
    s_lshl_b32 s42, s48, 6
    s_add_u32 s42, s42, 65536
    v_lshlrev_b32 v15, 4, v6
    v_add_u32 v187, s42, v15
    s_sub_u32 s49, s47, s31
    s_lshl_b32 s49, s49, 8
    s_add_u32 s49, s49, s63
    s_add_u32 s49, s49, 65536
    v_add_u32 v188, s49, v187
    s_getreg_b32 s58, hwreg(HW_REG_XCC_ID)
    s_mov_b32 s57, 1069066811
    v_mov_b32 v128, 0xffffff00
    v_mov_b32 v199, 1
    v_lshrrev_b32 v122, 2, v1
    v_bfe_u32 v123, v1, 3, 2
    v_xor_b32 v123, s3, v123
    v_lshlrev_b32 v123, 5, v123
    v_and_b32 v125, 3, v1
    v_lshl_add_u32 v123, v125, 3, v123
    v_lshl_add_u32 v14, v122, 7, v123
    v_add_u32 v13, 0x10000, v14
    s_lshl_b32 s48, s30, 8
    v_add_u32 v121, s48, v15
    s_lshl_b32 s48, s28, 7
    s_add_u32 s46, s48, s29
    s_lshl2_add_u32 s48, s46, s3
    s_lshl_b32 s48, s48, 7
    s_add_u32 s48, s48, 524288
    v_and_b32 v123, 4, v1
    v_lshl_add_u32 v123, v123, 4, v15
    v_lshl_add_u32 v123, v125, 14, v123
    v_add_u32 v182, s48, v123
    s_lshl_b32 s48, s46, 3
    s_add_u32 s48, s48, 393216
    v_lshl_add_u32 v183, v125, 8, s48
    v_mov_b32 v140, -1
    v_mov_b32 v141, -1
    v_mov_b32 v142, -1
    v_mov_b32 v143, -1
    s_mov_b32 exec_lo, 0x00ff00ff
    s_mov_b32 exec_hi, 0x00ff00ff
    global_store_dwordx4 v182, v[140:143], s[26:27]
    s_mov_b64 exec, 15
    global_store_dwordx2 v183, v[140:141], s[26:27]
    s_mov_b64 exec, -1
    s_cmp_lg_u32 s3, 0
    s_cbranch_scc1 L_noln
L_flx:
    ds_read_b32 v127, v7 offset:3596
    ds_read_b128 v[48:51], v5 offset:5120
    s_waitcnt lgkmcnt(0)
    v_cmp_gt_u32 vcc, 7, v127
    s_cbranch_vccnz L_flx
    v_lshlrev_b32 v144, 16, v48
    v_and_b32 v145, 0xffff0000, v48
    v_lshlrev_b32 v146, 16, v49
    v_and_b32 v147, 0xffff0000, v49
    v_lshlrev_b32 v148, 16, v50
    v_and_b32 v149, 0xffff0000, v50
    v_lshlrev_b32 v150, 16, v51
    v_and_b32 v151, 0xffff0000, v51
    v_readfirstlane_b32 s48, v144
    v_mov_b32 v156, 0x3b000000
    s_nop 0
    v_pk_add_f32 v[164:165], v[144:145], s[48:49] op_sel_hi:[1,0] neg_lo:[0,1] neg_hi:[0,1]
    v_pk_add_f32 v[166:167], v[146:147], s[48:49] op_sel_hi:[1,0] neg_lo:[0,1] neg_hi:[0,1]
    v_pk_add_f32 v[168:169], v[148:149], s[48:49] op_sel_hi:[1,0] neg_lo:[0,1] neg_hi:[0,1]
    v_pk_add_f32 v[170:171], v[150:151], s[48:49] op_sel_hi:[1,0] neg_lo:[0,1] neg_hi:[0,1]
    v_pk_add_f32 v[152:153], v[164:165], v[166:167]
    v_pk_mul_f32 v[154:155], v[164:165], v[164:165]
    v_pk_add_f32 v[152:153], v[152:153], v[168:169]
    v_pk_fma_f32 v[154:155], v[166:167], v[166:167], v[154:155]
    v_pk_add_f32 v[152:153], v[152:153], v[170:171]
    v_pk_fma_f32 v[154:155], v[168:169], v[168:169], v[154:155]
    v_add_f32 v152, v152, v153
    v_pk_fma_f32 v[154:155], v[170:171], v[170:171], v[154:155]
    v_add_f32 v154, v154, v155
    v_add_f32_dpp v152, v152, v152 quad_perm:[1,0,3,2] row_mask:0xf bank_mask:0xf
    s_nop 0
    v_add_f32_dpp v154, v154, v154 quad_perm:[1,0,3,2] row_mask:0xf bank_mask:0xf
    v_add_f32_dpp v152, v152, v152 quad_perm:[2,3,0,1] row_mask:0xf bank_mask:0xf
    s_nop 0
    v_add_f32_dpp v154, v154, v154 quad_perm:[2,3,0,1] row_mask:0xf bank_mask:0xf
    v_add_f32_dpp v152, v152, v152 row_half_mirror row_mask:0xf bank_mask:0xf
    s_nop 0
    v_add_f32_dpp v154, v154, v154 row_half_mirror row_mask:0xf bank_mask:0xf
    v_add_f32_dpp v152, v152, v152 row_mirror row_mask:0xf bank_mask:0xf
    s_nop 0
    v_add_f32_dpp v154, v154, v154 row_mirror row_mask:0xf bank_mask:0xf
    v_add_f32_dpp v152, v152, v152 row_bcast:15 row_mask:0xa bank_mask:0xf
    s_nop 0
    v_add_f32_dpp v154, v154, v154 row_bcast:15 row_mask:0xa bank_mask:0xf
    v_add_f32_dpp v152, v152, v152 row_bcast:31 row_mask:0xc bank_mask:0xf
    s_nop 0
    v_add_f32_dpp v154, v154, v154 row_bcast:31 row_mask:0xc bank_mask:0xf
    v_readlane_b32 s49, v152, 63
    v_readlane_b32 s50, v154, 63
    s_nop 0
    v_mul_f32 v157, s49, v156
    v_mul_f32 v158, s50, v156
    v_add_f32 v156, s48, v157
    v_fma_f32 v158, -v157, v157, v158
    v_max_f32 v158, 0, v158
    v_cvt_pk_bf16_f32 v156, v156, v158
    v_and_b32 v158, 0xffff0000, v156
    v_lshlrev_b32 v156, 16, v156
    v_add_f32 v158, 925353388, v158
    v_cvt_pk_bf16_f32 v158, v158, v158
    v_lshlrev_b32 v158, 16, v158
    v_sqrt_f32 v158, v158
    v_pk_add_f32 v[144:145], v[144:145], v[156:157] op_sel_hi:[1,0] neg_lo:[0,1] neg_hi:[0,1]
    v_cvt_pk_bf16_f32 v158, v158, v158
    v_lshlrev_b32 v158, 16, v158
    v_rcp_f32 v158, v158
    v_pk_add_f32 v[146:147], v[146:147], v[156:157] op_sel_hi:[1,0] neg_lo:[0,1] neg_hi:[0,1]
    v_pk_add_f32 v[148:149], v[148:149], v[156:157] op_sel_hi:[1,0] neg_lo:[0,1] neg_hi:[0,1]
    v_pk_add_f32 v[150:151], v[150:151], v[156:157] op_sel_hi:[1,0] neg_lo:[0,1] neg_hi:[0,1]
    v_cvt_pk_bf16_f32 v160, v144, v145
    v_cvt_pk_bf16_f32 v161, v146, v147
    v_cvt_pk_bf16_f32 v162, v148, v149
    v_cvt_pk_bf16_f32 v163, v150, v151
    v_lshlrev_b32 v144, 16, v160
    v_and_b32 v145, 0xffff0000, v160
    v_lshlrev_b32 v146, 16, v161
    v_and_b32 v147, 0xffff0000, v161
    v_lshlrev_b32 v148, 16, v162
    v_and_b32 v149, 0xffff0000, v162
    v_lshlrev_b32 v150, 16, v163
    v_and_b32 v151, 0xffff0000, v163
    v_pk_mul_f32 v[144:145], v[144:145], v[158:159] op_sel_hi:[1,0]
    v_pk_mul_f32 v[146:147], v[146:147], v[158:159] op_sel_hi:[1,0]
    v_pk_mul_f32 v[148:149], v[148:149], v[158:159] op_sel_hi:[1,0]
    v_pk_mul_f32 v[150:151], v[150:151], v[158:159] op_sel_hi:[1,0]
    v_cvt_pk_bf16_f32 v160, v144, v145
    v_cvt_pk_bf16_f32 v161, v146, v147
    v_cvt_pk_bf16_f32 v162, v148, v149
    v_cvt_pk_bf16_f32 v163, v150, v151
    ds_write_b128 v5, v[160:163] offset:0
    s_mov_b64 exec, 1
    ds_add_u32 v7, v199 offset:3588
    s_mov_b64 exec, -1
L_noln:
    s_waitcnt lgkmcnt(0)
    s_add_u32 s36, s36, 0x01010108
    s_bfe_u32 s38, s36, 0x80008
    s_bfe_u32 s39, s36, 0x80010
    s_lshr_b32 s40, s36, 24
    s_and_b32 s37, s36, 0xf8
    s_and_b32 s58, s58, 7
    s_or_b32 s41, s37, s58
L_fl1:
    ds_read_b32 v127, v7 offset:3588
    s_waitcnt lgkmcnt(0)
    v_cmp_gt_u32 vcc, 1, v127
    s_cbranch_vccnz L_fl1
L_fl2:
    ds_read_b32 v127, v7 offset:3596
    s_waitcnt lgkmcnt(0)
    v_cmp_gt_u32 vcc, 9, v127
    s_cbranch_vccnz L_fl2
    ds_read_b128 v[208:211], v121 offset:0
    ds_read_b128 v[212:215], v121 offset:64
    ds_read_b128 v[216:219], v121 offset:128
    ds_read_b128 v[220:223], v121 offset:192
    ds_read_b64_tr_b16 v[88:89], v14 offset:8192
    ds_read_b64_tr_b16 v[90:91], v14 offset:10240
    ds_read_b64_tr_b16 v[92:93], v14 offset:12288
    ds_read_b64_tr_b16 v[94:95], v14 offset:14336
    ds_read_b64_tr_b16 v[96:97], v14 offset:16384
    ds_read_b64_tr_b16 v[98:99], v14 offset:18432
    ds_read_b64_tr_b16 v[100:101], v14 offset:20480
    ds_read_b64_tr_b16 v[102:103], v14 offset:22528
    s_waitcnt lgkmcnt(6)
    v_mfma_f32_16x16x32_bf16 v[132:135], v[88:91], v[208:211], 0
    s_waitcnt lgkmcnt(4)
    v_mfma_f32_16x16x32_bf16 v[132:135], v[92:95], v[212:215], v[132:135]
    s_waitcnt lgkmcnt(2)
    v_mfma_f32_16x16x32_bf16 v[132:135], v[96:99], v[216:219], v[132:135]
    s_waitcnt lgkmcnt(0)
    v_mfma_f32_16x16x32_bf16 v[132:135], v[100:103], v[220:223], v[132:135]
    s_mov_b32 exec_lo, 0x00010001
    s_mov_b32 exec_hi, 0x00010001
    v_add_u32 v127, 1048576, v187
    s_nop 3
    s_waitcnt vmcnt(0)
    v_add_u32 v144, 0x80, v132
    v_add_u32 v145, 0x80, v133
    v_add_u32 v146, 0x80, v134
    v_add_u32 v147, 0x80, v135
    v_and_or_b32 v144, v144, v128, s41
    v_and_or_b32 v145, v145, v128, s38
    v_and_or_b32 v146, v146, v128, s39
    v_and_or_b32 v147, v147, v128, s40
    global_store_dwordx4 v187, v[144:147], s[26:27]
    global_store_dwordx4 v127, v[144:147], s[26:27] sc1
    s_mov_b64 exec, -1
    s_branch L_p2
    .p2align 12
L_p2:
    s_lshl2_add_u32 s48, s31, s3
    s_lshl_b32 s48, s48, 6
    s_add_u32 s48, s48, s54
    s_lshl_b32 s48, s48, 6
    s_add_u32 s98, s48, 262144
    s_lshl2_add_u32 s48, s60, s3
    s_lshl_b32 s48, s48, 6
    s_add_u32 s48, s48, s34
    s_lshl_b32 s48, s48, 6
    s_add_u32 s48, s48, s63
    s_add_u32 s99, s48, 264192
    v_add_u32 v197, s98, v15
    v_add_u32 v198, s99, v15
    s_lshl_b32 s48, s28, 13
    s_add_u32 s48, s48, 65536
    s_lshl_b32 s50, s3, 9
    s_add_u32 s48, s48, s50
    v_and_b32 v121, 31, v1
    v_lshrrev_b32 v123, 5, v1
    v_lshlrev_b32 v124, 12, v123
    v_lshl_add_u32 v124, v121, 4, v124
    v_add_u32 v189, s48, v124
    v_lshlrev_b32 v123, 2, v123
    v_lshl_add_u32 v123, v121, 3, v123
    s_mul_i32 s48, s3, 288
    v_add_u32 v190, s48, v123
L_fl3:
    ds_read_b32 v127, v7 offset:3596
    s_waitcnt lgkmcnt(0)
    v_cmp_gt_u32 vcc, 12, v127
    s_cbranch_vccnz L_fl3
    global_load_dwordx4 v[104:107], v189, s[26:27] offset:0 sc1
    global_load_dwordx4 v[108:111], v189, s[26:27] offset:2048 sc1
L_fl4:
    ds_read_b32 v127, v7 offset:3596
    s_waitcnt lgkmcnt(0)
    v_cmp_gt_u32 vcc, 14, v127
    s_cbranch_vccnz L_fl4
    ds_read_b64_tr_b16 v[88:89], v14 offset:24576
    ds_read_b64_tr_b16 v[90:91], v14 offset:26624
    ds_read_b64_tr_b16 v[92:93], v14 offset:28672
    ds_read_b64_tr_b16 v[94:95], v14 offset:30720
    ds_read_b64_tr_b16 v[96:97], v14 offset:32768
    ds_read_b64_tr_b16 v[98:99], v14 offset:34816
    ds_read_b64_tr_b16 v[100:101], v14 offset:36864
    ds_read_b64_tr_b16 v[102:103], v14 offset:38912
    s_waitcnt lgkmcnt(6)
    v_mfma_f32_16x16x32_bf16 v[132:135], v[88:91], v[208:211], 0
    s_waitcnt lgkmcnt(4)
    v_mfma_f32_16x16x32_bf16 v[132:135], v[92:95], v[212:215], v[132:135]
    s_waitcnt lgkmcnt(2)
    v_mfma_f32_16x16x32_bf16 v[132:135], v[96:99], v[216:219], v[132:135]
    s_waitcnt lgkmcnt(0)
    v_mfma_f32_16x16x32_bf16 v[132:135], v[100:103], v[220:223], v[132:135]
    s_mov_b32 exec_lo, 0x00010001
    s_mov_b32 exec_hi, 0x00010001
    v_add_u32 v127, 1048576, v188
    s_nop 3
    s_nop 0
    v_add_u32 v144, 0x80, v132
    v_add_u32 v145, 0x80, v133
    v_add_u32 v146, 0x80, v134
    v_add_u32 v147, 0x80, v135
    v_and_or_b32 v144, v144, v128, s41
    v_and_or_b32 v145, v145, v128, s38
    v_and_or_b32 v146, v146, v128, s39
    v_and_or_b32 v147, v147, v128, s40
    global_store_dwordx4 v188, v[144:147], s[26:27]
    global_store_dwordx4 v127, v[144:147], s[26:27] sc1
    s_mov_b64 exec, -1
    s_mov_b32 s44, 0xf0f0f0f0
    s_mov_b32 s45, 0xf0f0f0f0
    s_lshl_b32 s49, s3, 1
    v_and_b32 v126, 7, v122
    v_xor_b32 v126, s49, v126
    v_lshlrev_b32 v126, 5, v126
    v_lshl_add_u32 v126, v125, 3, v126
    v_lshl_add_u32 v129, v122, 8, v126
    v_add_u32 v129, 81920, v129
    v_xor_b32 v130, 32, v129
    s_add_u32 s49, s62, 40960
    v_xor_b32 v131, v4, v6
    v_lshlrev_b32 v131, 4, v131
    v_lshl_add_u32 v131, v4, 8, v131
    v_add_u32 v131, s49, v131
    v_xor_b32 v8, 64, v131
    v_xor_b32 v9, 0x80, v131
    v_xor_b32 v10, 0xc0, v131
    v_mov_b32 v124, 262144
    v_mul_u32_u24 v126, 288, v125
    v_add_u32 v126, v126, v15
    v_cndmask_b32 v179, v126, v124, s[44:45]
    v_cndmask_b32 v180, v124, v126, s[44:45]
    s_mov_b32 s48, 0xff00ff00
    s_mov_b32 s49, 0xff00ff00
    v_cndmask_b32 v176, v126, v124, s[48:49]
    v_cndmask_b32 v177, v124, v126, s[48:49]
    v_and_b32 v123, 12, v1
    s_lshl_b32 s48, s3, 6
    v_add3_u32 v178, v126, v123, s48
    v_bfrev_b32 v123, 1
    ds_write_b32 v178, v123 offset:2304
    v_lshlrev_b32 v181, 4, v125
    s_lshl_b32 s48, s54, 7
    s_add_u32 s48, s48, s3
    s_lshl_b32 s48, s48, 7
    s_add_u32 s48, s48, 524288
    v_lshrrev_b32 v123, 3, v1
    v_and_b32 v124, 7, v1
    v_lshlrev_b32 v125, 4, v124
    v_lshl_add_u32 v125, v123, 11, v125
    v_add_u32 v184, s48, v125
    s_lshl_b32 s48, s54, 8
    s_add_u32 s48, s48, 393216
    v_lshrrev_b32 v125, 1, v181
    v_lshl_add_u32 v125, v123, 5, v125
    v_add_u32 v185, s48, v125
    s_lshl_b32 s48, s3, 6
    v_lshlrev_b32 v125, 3, v124
    v_lshl_add_u32 v125, v6, 1, v125
    v_add_u32 v186, s48, v125
    v_mov_b32 v192, 0x3f803f80
    v_mov_b32 v193, 0x3f803f80
    v_mov_b32 v194, 0x3f803f80
    v_mov_b32 v195, 0x3f803f80
    s_mov_b32 s55, 0
    s_mov_b32 s35, 0
    s_lshl_b32 s59, s3, 3
    s_lshr_b32 s59, 370414096, s59
    s_and_b32 s59, s59, 0xff
L_fl5:
    ds_read_b32 v127, v7 offset:3596
    s_waitcnt lgkmcnt(0)
    v_cmp_gt_u32 vcc, 17, v127
    s_cbranch_vccnz L_fl5
    global_load_dwordx4 v[244:247], v189, s[26:27] offset:0 sc1
    global_load_dwordx4 v[248:251], v189, s[26:27] offset:2048 sc1
    s_mov_b64 exec, 0xff
    global_load_dword v52, v182, s[26:27] nt
    global_load_dword v53, v183, s[26:27] nt
    s_mov_b64 exec, -1
    s_waitcnt vmcnt(6)
L_chk1:
    v_xor_b32 v104, s41, v104
    v_xor_b32 v105, s38, v105
    v_xor_b32 v106, s39, v106
    v_xor_b32 v107, s40, v107
    v_xor_b32 v108, s41, v108
    v_xor_b32 v109, s38, v109
    v_xor_b32 v110, s39, v110
    v_xor_b32 v111, s40, v111
    v_or_b32 v122, v104, v108
    v_or3_b32 v123, v105, v106, v107
    v_or3_b32 v123, v123, v109, v110
    v_or_b32 v123, v123, v111
    v_or_b32 v124, v122, v123
    v_and_b32 v124, 0xff, v124
    v_cmp_ne_u32 vcc, 0, v124
    s_cbranch_vccnz L_slow1
L_ok1:
    v_pk_add_f32 v[104:105], v[104:105], v[108:109]
    v_pk_add_f32 v[106:107], v[106:107], v[110:111]
    s_nop 1
    v_permlane32_swap_b32 v104, v106
    v_permlane32_swap_b32 v105, v107
    v_pk_add_f32 v[104:105], v[104:105], v[106:107]
    v_cvt_pk_bf16_f32 v144, v104, v105
    ds_write_b32 v190, v144 offset:1024
    s_mov_b64 exec, 1
    ds_add_u32 v7, v199 offset:3600
    s_mov_b64 exec, -1
L_kq:
    ds_read_b32 v127, v7 offset:3596
    ds_read_b32 v126, v7 offset:3600
    s_waitcnt lgkmcnt(0)
    v_cmp_le_u32 vcc, s59, v127
    s_cbranch_vccnz L_kfirst
    v_cmp_gt_u32 vcc, 4, v126
    s_cbranch_vccnz L_kq
    ds_read_b128 v[56:59], v176 offset:1024
    ds_read_b128 v[60:63], v176 offset:1088
    ds_read_b128 v[64:67], v176 offset:1152
    ds_read_b128 v[68:71], v176 offset:1216
    ds_read_b128 v[72:75], v177 offset:1024
    ds_read_b128 v[76:79], v177 offset:1088
    ds_read_b128 v[80:83], v177 offset:1152
    ds_read_b128 v[84:87], v177 offset:1216
L_fl6:
    ds_read_b32 v127, v7 offset:3596
    s_waitcnt lgkmcnt(0)
    v_cmp_gt_u32 vcc, s59, v127
    s_cbranch_vccnz L_fl6
    ds_read_b128 v[16:19], v131 offset:0
    ds_read_b128 v[20:23], v8 offset:0
    ds_read_b128 v[24:27], v9 offset:0
    ds_read_b128 v[28:31], v10 offset:0
    ds_read_b128 v[32:35], v131 offset:4096
    ds_read_b128 v[36:39], v8 offset:4096
    ds_read_b128 v[40:43], v9 offset:4096
    ds_read_b128 v[44:47], v10 offset:4096
L_kqgo:
    s_waitcnt lgkmcnt(7)
    v_mfma_f32_16x16x32_bf16 v[132:135], v[16:19], v[56:59], 0
    s_waitcnt lgkmcnt(6)
    v_mfma_f32_16x16x32_bf16 v[132:135], v[20:23], v[60:63], v[132:135]
    s_waitcnt lgkmcnt(5)
    v_mfma_f32_16x16x32_bf16 v[132:135], v[24:27], v[64:67], v[132:135]
    s_waitcnt lgkmcnt(4)
    v_mfma_f32_16x16x32_bf16 v[132:135], v[28:31], v[68:71], v[132:135]
    s_waitcnt lgkmcnt(3)
    v_mfma_f32_16x16x32_bf16 v[132:135], v[32:35], v[72:75], v[132:135]
    s_waitcnt lgkmcnt(2)
    v_mfma_f32_16x16x32_bf16 v[132:135], v[36:39], v[76:79], v[132:135]
    s_waitcnt lgkmcnt(1)
    v_mfma_f32_16x16x32_bf16 v[132:135], v[40:43], v[80:83], v[132:135]
    s_waitcnt lgkmcnt(0)
    v_mfma_f32_16x16x32_bf16 v[132:135], v[44:47], v[84:87], v[132:135]
    s_mov_b32 s48, 1035273459
    s_lshl_b32 s49, s3, 2
    v_add_u32 v148, s49, v181
    s_nop 4
    v_cndmask_b32 v144, v132, v134, s[44:45]
    v_cndmask_b32 v145, v133, v135, s[44:45]
    v_cvt_pk_bf16_f32 v147, v144, v145
    v_lshlrev_b32 v144, 16, v147
    v_and_b32 v145, 0xffff0000, v147
    v_mul_f32 v144, s48, v144
    v_mul_f32 v145, s48, v145
    v_cvt_pk_bf16_f32 v147, v144, v145
    v_lshlrev_b32 v144, 16, v147
    v_and_b32 v145, 0xffff0000, v147
    v_max_f32 v146, v144, v145
    s_nop 1
    v_max_f32_dpp v146, v146, v146 row_ror:4 row_mask:0xf bank_mask:0xf
    s_nop 1
    v_max_f32_dpp v146, v146, v146 row_ror:8 row_mask:0xf bank_mask:0xf
    v_mov_b32 v147, v146
    s_nop 1
    v_permlane16_swap_b32 v146, v147
    v_max_f32 v146, v146, v147
    v_mov_b32 v147, v146
    s_nop 1
    v_permlane32_swap_b32 v146, v147
    v_max_f32 v146, v146, v147
    v_or_b32 v146, 1, v146
    ds_write_b32 v148, v146 offset:3648
    ds_read_b32 v152, v7 offset:3584
    s_mov_b32 s55, 0
L_mx:
    ds_read_b128 v[148:151], v181 offset:3648
    s_waitcnt lgkmcnt(0)
    v_bitop3_b32 v147, v148, v149, v150 bitop3:0x80
    v_max3_f32 v146, v148, v149, v150
    v_bitop3_b32 v147, v147, v151, 1 bitop3:0x80
    v_max_f32 v146, v146, v151
    v_cmp_eq_u32 vcc, 0, v147
    v_and_b32 v146, -2, v146
    s_cbranch_vccnz L_mx
    v_mul_f32 v147, s57, v146
    v_fma_f32 v144, v144, s57, -v147
    v_fma_f32 v145, v145, s57, -v147
    v_exp_f32 v144, v144
    v_exp_f32 v145, v145
    v_readfirstlane_b32 s56, v152
    v_cvt_pk_bf16_f32 v147, v144, v145
    ds_write_b32 v178, v147 offset:2304
    v_mov_b32 v148, v146
L_pp:
    ds_read_b128 v[56:59], v179 offset:2304
    ds_read_b128 v[64:67], v179 offset:2368
    ds_read_b128 v[72:75], v179 offset:2432
    ds_read_b128 v[80:83], v179 offset:2496
    ds_read_b128 v[60:63], v180 offset:2304
    ds_read_b128 v[68:71], v180 offset:2368
    ds_read_b128 v[76:79], v180 offset:2432
    ds_read_b128 v[84:87], v180 offset:2496
    s_waitcnt lgkmcnt(4)
    v_or3_b32 v122, v56, v57, v58
    v_or3_b32 v122, v122, v59, v64
    v_or3_b32 v122, v122, v65, v66
    v_or3_b32 v122, v122, v67, v72
    v_or3_b32 v122, v122, v73, v74
    v_or3_b32 v122, v122, v75, v80
    v_or3_b32 v122, v122, v81, v82
    v_or_b32 v122, v122, v83
    v_cmp_gt_i32 vcc, 0, v122
    s_cbranch_vccnz L_ppr
L_ppok:
    v_mfma_f32_16x16x32_bf16 v[140:143], v[192:195], v[56:59], 0
    v_mfma_f32_16x16x32_bf16 v[140:143], v[192:195], v[64:67], v[140:143]
    v_mfma_f32_16x16x32_bf16 v[140:143], v[192:195], v[72:75], v[140:143]
    v_mfma_f32_16x16x32_bf16 v[140:143], v[192:195], v[80:83], v[140:143]
    s_mov_b64 exec, 15
    s_nop 6
    v_and_b32 v149, v128, v140
    global_store_dwordx2 v183, v[148:149], s[26:27]
    s_mov_b64 exec, -1
    ds_read_b64 v[152:153], v7 offset:3592
    s_mov_b32 s35, 1
    s_waitcnt lgkmcnt(0)
    v_cmp_eq_u32 vcc, 1, v152
    v_cmp_le_u32 s[48:49], 24, v153
    s_and_b64 vcc, vcc, s[48:49]
    s_cbranch_vccz L_hskip
    s_mov_b32 s35, 0
    ds_read_b128 v[16:19], v15 offset:4096
    ds_read_b128 v[20:23], v15 offset:4160
    ds_read_b64_tr_b16 v[208:209], v13 offset:8192
    ds_read_b64_tr_b16 v[210:211], v13 offset:10240
    ds_read_b64_tr_b16 v[212:213], v13 offset:12288
    ds_read_b64_tr_b16 v[214:215], v13 offset:14336
    s_waitcnt lgkmcnt(2)
    v_mfma_f32_16x16x32_bf16 v[136:139], v[208:211], v[16:19], 0
    s_waitcnt lgkmcnt(0)
    v_mfma_f32_16x16x32_bf16 v[136:139], v[212:215], v[20:23], v[136:139]
    s_nop 4
    s_mov_b32 exec_lo, 0x00010001
    s_mov_b32 exec_hi, 0x00010001
    s_mov_b32 s55, 0
    v_and_or_b32 v152, v136, v128, s37
    v_and_or_b32 v153, v137, v128, s38
    v_and_or_b32 v154, v138, v128, s39
    v_and_or_b32 v155, v139, v128, s40
    global_store_dwordx4 v198, v[152:155], s[26:27] sc1
    s_mov_b64 exec, -1
L_hskip:
L_fl7:
    ds_read_b32 v127, v7 offset:3596
    s_waitcnt lgkmcnt(0)
    v_cmp_gt_u32 vcc, 31, v127
    s_cbranch_vccnz L_fl7
    ds_read_b64_tr_b16 v[88:89], v129 offset:0
    ds_read_b64_tr_b16 v[90:91], v129 offset:4096
    ds_read_b64_tr_b16 v[92:93], v130 offset:0
    ds_read_b64_tr_b16 v[94:95], v130 offset:4096
    ds_read_b64_tr_b16 v[96:97], v129 offset:8192
    ds_read_b64_tr_b16 v[98:99], v129 offset:12288
    ds_read_b64_tr_b16 v[100:101], v130 offset:8192
    ds_read_b64_tr_b16 v[102:103], v130 offset:12288
    ds_read_b64_tr_b16 v[104:105], v129 offset:16384
    ds_read_b64_tr_b16 v[106:107], v129 offset:20480
    ds_read_b64_tr_b16 v[108:109], v130 offset:16384
    ds_read_b64_tr_b16 v[110:111], v130 offset:20480
    s_waitcnt lgkmcnt(10)
    v_mfma_f32_16x16x32_bf16 v[132:135], v[88:91], v[56:59], 0
    s_waitcnt lgkmcnt(8)
    v_mfma_f32_16x16x32_bf16 v[132:135], v[92:95], v[60:63], v[132:135]
    s_waitcnt lgkmcnt(6)
    v_mfma_f32_16x16x32_bf16 v[132:135], v[96:99], v[64:67], v[132:135]
    s_waitcnt lgkmcnt(4)
    v_mfma_f32_16x16x32_bf16 v[132:135], v[100:103], v[68:71], v[132:135]
    s_waitcnt lgkmcnt(2)
    v_mfma_f32_16x16x32_bf16 v[132:135], v[104:107], v[72:75], v[132:135]
    s_waitcnt lgkmcnt(0)
    v_mfma_f32_16x16x32_bf16 v[132:135], v[108:111], v[76:79], v[132:135]
    s_barrier
    ds_read_b64_tr_b16 v[112:113], v129 offset:24576
    ds_read_b64_tr_b16 v[114:115], v129 offset:28672
    ds_read_b64_tr_b16 v[116:117], v130 offset:24576
    ds_read_b64_tr_b16 v[118:119], v130 offset:28672
    s_waitcnt lgkmcnt(2)
    v_mfma_f32_16x16x32_bf16 v[132:135], v[112:115], v[80:83], v[132:135]
    s_waitcnt lgkmcnt(0)
    v_mfma_f32_16x16x32_bf16 v[132:135], v[116:119], v[84:87], v[132:135]
    s_mov_b32 exec_lo, 0x00ff00ff
    s_mov_b32 exec_hi, 0x00ff00ff
    s_cmp_lg_u32 s56, 0
    s_nop 3
    s_cbranch_scc1 L_pub2_far
    global_store_dwordx4 v182, v[132:135], s[26:27]
L_pub2_done:
    s_mov_b64 exec, -1
    s_cmp_lg_u32 s35, 0
    s_cbranch_scc0 L_hret
L_hw:
    ds_read_b32 v127, v7 offset:3592
    s_waitcnt lgkmcnt(0)
    v_cmp_ne_u32 vcc, 1, v127
    s_cbranch_vccnz L_hlate
    ds_read_b128 v[16:19], v15 offset:4096
    ds_read_b128 v[20:23], v15 offset:4160
    ds_read_b64_tr_b16 v[208:209], v13 offset:8192
    ds_read_b64_tr_b16 v[210:211], v13 offset:10240
    ds_read_b64_tr_b16 v[212:213], v13 offset:12288
    ds_read_b64_tr_b16 v[214:215], v13 offset:14336
    s_waitcnt lgkmcnt(2)
    v_mfma_f32_16x16x32_bf16 v[136:139], v[208:211], v[16:19], 0
    s_waitcnt lgkmcnt(0)
    v_mfma_f32_16x16x32_bf16 v[136:139], v[212:215], v[20:23], v[136:139]
    s_nop 4
    s_mov_b32 exec_lo, 0x00010001
    s_mov_b32 exec_hi, 0x00010001
    s_mov_b32 s55, 0
    v_and_or_b32 v152, v136, v128, s37
    v_and_or_b32 v153, v137, v128, s38
    v_and_or_b32 v154, v138, v128, s39
    v_and_or_b32 v155, v139, v128, s40
    global_store_dwordx4 v198, v[152:155], s[26:27] sc1
    s_mov_b64 exec, -1
L_hret:
L_fl8:
    ds_read_b32 v127, v7 offset:3596
    s_waitcnt lgkmcnt(0)
    v_cmp_gt_u32 vcc, 35, v127
    s_cbranch_vccnz L_fl8
    global_load_dwordx2 v[52:53], v185, s[26:27] sc1
    global_load_dwordx4 v[160:163], v184, s[26:27] offset:0 sc1
    global_load_dwordx4 v[164:167], v184, s[26:27] offset:512 sc1
    global_load_dwordx4 v[168:171], v184, s[26:27] offset:1024 sc1
    global_load_dwordx4 v[172:175], v184, s[26:27] offset:1536 sc1
    s_barrier
    ds_read_b64_tr_b16 v[88:89], v13 offset:49152
    ds_read_b64_tr_b16 v[90:91], v13 offset:51200
    ds_read_b64_tr_b16 v[92:93], v13 offset:53248
    ds_read_b64_tr_b16 v[94:95], v13 offset:55296
    ds_read_b64_tr_b16 v[96:97], v13 offset:57344
    ds_read_b64_tr_b16 v[98:99], v13 offset:59392
    ds_read_b64_tr_b16 v[100:101], v13 offset:61440
    ds_read_b64_tr_b16 v[102:103], v13 offset:63488
    s_cmp_lg_u32 s56, 0
    s_cbranch_scc1 L_far_get
    s_waitcnt vmcnt(4)
L_chk2:
    v_max_f32_dpp v145, v52, v52 quad_perm:[1,0,3,2] row_mask:0xf bank_mask:0xf
    v_cmp_eq_u32 vcc, -1, v53
    s_cbranch_vccnz L_slows
    v_max_f32_dpp v145, v145, v145 quad_perm:[2,3,0,1] row_mask:0xf bank_mask:0xf
    s_nop 1
    v_max_f32_dpp v145, v145, v145 row_ror:8 row_mask:0xf bank_mask:0xf
    v_mov_b32 v148, v145
    s_nop 1
    v_permlane16_swap_b32 v145, v148
    v_max_f32 v145, v145, v148
    v_mov_b32 v148, v145
    s_nop 1
    v_permlane32_swap_b32 v145, v148
    v_max_f32 v145, v145, v148
    v_sub_f32 v146, v52, v145
    v_mul_f32 v146, s57, v146
    v_exp_f32 v146, v146
    s_nop 0
    v_mul_f32 v147, v146, v53
    s_waitcnt vmcnt(0) lgkmcnt(8)
    v_max3_u32 v122, v161, v163, v165
    v_add_f32_dpp v147, v147, v147 quad_perm:[1,0,3,2] row_mask:0xf bank_mask:0xf
    v_max3_u32 v122, v122, v167, v169
    v_max3_u32 v122, v122, v171, v173
    v_add_f32_dpp v147, v147, v147 quad_perm:[2,3,0,1] row_mask:0xf bank_mask:0xf
    v_max_u32 v122, v122, v175
    v_cmp_eq_u32 vcc, -1, v122
    v_add_f32_dpp v147, v147, v147 row_ror:8 row_mask:0xf bank_mask:0xf
    v_mov_b32 v148, v147
    s_nop 1
    v_permlane16_swap_b32 v147, v148
    v_add_f32 v147, v147, v148
    v_mov_b32 v148, v147
    s_nop 1
    v_permlane32_swap_b32 v147, v148
    v_add_f32 v147, v147, v148
    v_rcp_f32 v147, v147
    s_cbranch_vccnz L_slow2
L_ok2:
    v_mul_f32_dpp v152, v146, v160 quad_perm:[0,0,0,0] row_mask:0xf bank_mask:0xf
    v_mul_f32_dpp v153, v146, v161 quad_perm:[0,0,0,0] row_mask:0xf bank_mask:0xf
    v_mul_f32_dpp v154, v146, v162 quad_perm:[0,0,0,0] row_mask:0xf bank_mask:0xf
    v_mul_f32_dpp v155, v146, v163 quad_perm:[0,0,0,0] row_mask:0xf bank_mask:0xf
    v_fmac_f32_dpp v152, v146, v164 quad_perm:[1,1,1,1] row_mask:0xf bank_mask:0xf
    v_fmac_f32_dpp v153, v146, v165 quad_perm:[1,1,1,1] row_mask:0xf bank_mask:0xf
    v_fmac_f32_dpp v154, v146, v166 quad_perm:[1,1,1,1] row_mask:0xf bank_mask:0xf
    v_fmac_f32_dpp v155, v146, v167 quad_perm:[1,1,1,1] row_mask:0xf bank_mask:0xf
    v_fmac_f32_dpp v152, v146, v168 quad_perm:[2,2,2,2] row_mask:0xf bank_mask:0xf
    v_fmac_f32_dpp v153, v146, v169 quad_perm:[2,2,2,2] row_mask:0xf bank_mask:0xf
    v_fmac_f32_dpp v154, v146, v170 quad_perm:[2,2,2,2] row_mask:0xf bank_mask:0xf
    v_fmac_f32_dpp v155, v146, v171 quad_perm:[2,2,2,2] row_mask:0xf bank_mask:0xf
    v_fmac_f32_dpp v152, v146, v172 quad_perm:[3,3,3,3] row_mask:0xf bank_mask:0xf
    v_fmac_f32_dpp v154, v146, v174 quad_perm:[3,3,3,3] row_mask:0xf bank_mask:0xf
    v_fmac_f32_dpp v153, v146, v173 quad_perm:[3,3,3,3] row_mask:0xf bank_mask:0xf
    v_fmac_f32_dpp v155, v146, v175 quad_perm:[3,3,3,3] row_mask:0xf bank_mask:0xf
    v_permlane32_swap_b32 v152, v154
    s_nop 0
    v_permlane32_swap_b32 v153, v155
    v_pk_add_f32 v[152:153], v[152:153], v[154:155]
    s_nop 1
    v_permlane16_swap_b32 v152, v153
    v_add_f32 v152, v152, v153
    s_nop 1
    v_add_f32_dpp v152, v152, v152 row_ror:8 row_mask:0xf bank_mask:0xf
    v_mul_f32 v152, v152, v147
    v_cvt_pk_bf16_f32 v152, v152, v152
    ds_write_b16 v186, v152 offset:3840
    s_waitcnt lgkmcnt(0)
    s_barrier
    ds_read_b128 v[56:59], v15 offset:3840
    ds_read_b128 v[60:63], v15 offset:3904
    ds_read_b128 v[64:67], v15 offset:3968
    ds_read_b128 v[68:71], v15 offset:4032
    s_waitcnt lgkmcnt(3)
    v_mfma_f32_16x16x32_bf16 v[136:139], v[88:91], v[56:59], 0
    s_waitcnt lgkmcnt(2)
    v_mfma_f32_16x16x32_bf16 v[136:139], v[92:95], v[60:63], v[136:139]
    s_waitcnt lgkmcnt(1)
    v_mfma_f32_16x16x32_bf16 v[136:139], v[96:99], v[64:67], v[136:139]
    s_waitcnt lgkmcnt(0)
    v_mfma_f32_16x16x32_bf16 v[136:139], v[100:103], v[68:71], v[136:139]
    s_mov_b32 exec_lo, 0x00010001
    s_mov_b32 exec_hi, 0x00010001
    s_nop 5
    v_and_or_b32 v144, v136, v128, s37
    v_and_or_b32 v145, v137, v128, s38
    v_and_or_b32 v146, v138, v128, s39
    v_and_or_b32 v147, v139, v128, s40
    global_store_dwordx4 v197, v[144:147], s[26:27] sc1
L_fin:
L_end:
    s_endpgm
L_slow2:
    s_mov_b64 exec, vcc
    global_load_dwordx4 v[160:163], v184, s[26:27] offset:0 sc1
    global_load_dwordx4 v[164:167], v184, s[26:27] offset:512 sc1
    global_load_dwordx4 v[168:171], v184, s[26:27] offset:1024 sc1
    global_load_dwordx4 v[172:175], v184, s[26:27] offset:1536 sc1
    s_add_u32 s55, s55, 1
    s_cmp_ge_u32 s55, 262144
    s_cbranch_scc1 L_done2
    s_waitcnt vmcnt(0)
    v_max3_u32 v122, v161, v163, v165
    v_max3_u32 v122, v122, v167, v169
    v_max3_u32 v122, v122, v171, v173
    v_max_u32 v122, v122, v175
    v_cmp_eq_u32 vcc, -1, v122
    s_cbranch_vccnz L_slow2
    s_mov_b64 exec, -1
    s_branch L_ok2
L_slows:
    s_mov_b64 exec, vcc
    global_load_dwordx2 v[52:53], v185, s[26:27] sc1
    s_add_u32 s55, s55, 1
    s_cmp_ge_u32 s55, 262144
    s_cbranch_scc1 L_done2
    s_waitcnt vmcnt(0)
    v_cmp_eq_u32 vcc, -1, v53
    s_cbranch_vccnz L_slows
    s_mov_b64 exec, -1
    s_branch L_chk2
L_done2:
    s_endpgm
L_kfirst:
    ds_read_b128 v[16:19], v131 offset:0
    ds_read_b128 v[20:23], v8 offset:0
    ds_read_b128 v[24:27], v9 offset:0
    ds_read_b128 v[28:31], v10 offset:0
    ds_read_b128 v[32:35], v131 offset:4096
    ds_read_b128 v[36:39], v8 offset:4096
    ds_read_b128 v[40:43], v9 offset:4096
    ds_read_b128 v[44:47], v10 offset:4096
L_fl9:
    ds_read_b32 v127, v7 offset:3600
    s_waitcnt lgkmcnt(0)
    v_cmp_gt_u32 vcc, 4, v127
    s_cbranch_vccnz L_fl9
    ds_read_b128 v[56:59], v176 offset:1024
    ds_read_b128 v[60:63], v176 offset:1088
    ds_read_b128 v[64:67], v176 offset:1152
    ds_read_b128 v[68:71], v176 offset:1216
    ds_read_b128 v[72:75], v177 offset:1024
    ds_read_b128 v[76:79], v177 offset:1088
    ds_read_b128 v[80:83], v177 offset:1152
    ds_read_b128 v[84:87], v177 offset:1216
    s_branch L_kqgo
L_slow1:
    v_and_b32 v124, 0xf8, v122
    v_and_b32 v125, 0xff, v123
    v_or_b32 v124, v124, v125
    v_cmp_ne_u32 vcc, 0, v124
    s_cbranch_vccnz L_retry1
L_nl1:
    s_mov_b64 exec, -1
    v_or_b32 v124, v104, v108
    v_and_b32 v124, 7, v124
    v_cmp_ne_u32 vcc, 0, v124
    s_cbranch_vccz L_ok1
    ds_write_b32 v7, v199 offset:3584
    v_and_b32 v104, -8, v104
    v_and_b32 v108, -8, v108
    s_branch L_ok1
L_retry1:
    s_add_u32 s55, s55, 1
    s_cmp_ge_u32 s55, 262144
    s_cbranch_scc1 L_nl1
    s_cmp_lg_u32 s55, 1
    s_cbranch_scc1 L_retry1b
    s_waitcnt vmcnt(2)
    v_pk_mov_b32 v[104:105], v[244:245], v[244:245] op_sel:[0,1]
    v_pk_mov_b32 v[106:107], v[246:247], v[246:247] op_sel:[0,1]
    v_pk_mov_b32 v[108:109], v[248:249], v[248:249] op_sel:[0,1]
    v_pk_mov_b32 v[110:111], v[250:251], v[250:251] op_sel:[0,1]
    s_branch L_chk1
L_retry1b:
    s_mov_b64 exec, vcc
    global_load_dwordx4 v[104:107], v189, s[26:27] offset:0 sc1
    global_load_dwordx4 v[108:111], v189, s[26:27] offset:2048 sc1
    v_xor_b32 v189, 1048576, v189
    s_waitcnt vmcnt(0)
    v_xor_b32 v104, s41, v104
    v_xor_b32 v105, s38, v105
    v_xor_b32 v106, s39, v106
    v_xor_b32 v107, s40, v107
    v_xor_b32 v108, s41, v108
    v_xor_b32 v109, s38, v109
    v_xor_b32 v110, s39, v110
    v_xor_b32 v111, s40, v111
    v_or_b32 v122, v104, v108
    v_or3_b32 v123, v105, v106, v107
    v_or3_b32 v123, v123, v109, v110
    v_or_b32 v123, v123, v111
    v_or_b32 v124, v122, v123
    v_and_b32 v124, 0xff, v124
    v_cmp_ne_u32 vcc, 0, v124
    s_branch L_slow1
L_hb0:
    s_waitcnt lgkmcnt(0)
    s_add_u32 s36, s36, 0x01010108
    s_bfe_u32 s38, s36, 0x80008
    s_bfe_u32 s39, s36, 0x80010
    s_lshr_b32 s40, s36, 24
    s_and_b32 s37, s36, 0xf8
    s_waitcnt vmcnt(24)
    v_xor_b32 v200, s37, v200
    v_xor_b32 v201, s38, v201
    v_xor_b32 v202, s39, v202
    v_xor_b32 v203, s40, v203
    v_xor_b32 v204, s37, v204
    v_xor_b32 v205, s38, v205
    v_xor_b32 v206, s39, v206
    v_xor_b32 v207, s40, v207
    v_and_b32 v200, -8, v200
    v_and_b32 v204, -8, v204
    v_or3_b32 v122, v200, v201, v202
    v_or3_b32 v122, v122, v203, v204
    v_or3_b32 v122, v122, v205, v206
    v_or_b32 v122, v122, v207
    v_and_b32 v124, 0xff, v122
    v_cmp_ne_u32 vcc, 0, v124
    s_mov_b32 s35, 1
    s_cbranch_vccnz L_lre
    s_mov_b32 s35, 0
    v_pk_add_f32 v[200:201], v[200:201], v[204:205]
    v_pk_add_f32 v[202:203], v[202:203], v[206:207]
    v_lshlrev_b32 v122, 1, v1
    s_nop 0
    v_permlane32_swap_b32 v200, v202
    v_permlane32_swap_b32 v201, v203
    v_pk_add_f32 v[200:201], v[200:201], v[202:203]
    v_cvt_pk_bf16_f32 v200, v200, v201
    ds_write_b32 v196, v200 offset:6144
    ds_read_u16 v153, v122 offset:6144
    ds_read_u16 v154, v122 offset:6272
    s_waitcnt lgkmcnt(0)
    v_lshlrev_b32 v153, 16, v153
    v_mul_f32 v155, s57, v153
    v_exp_f32 v155, -v155
    v_lshlrev_b32 v154, 16, v154
    v_add_f32 v155, 1.0, v155
    v_rcp_f32 v155, v155
    s_nop 0
    v_mul_f32 v153, v153, v155
    v_cvt_pk_bf16_f32 v153, v153, v153
    v_lshlrev_b32 v153, 16, v153
    v_mul_f32 v153, v153, v154
    v_cvt_pk_bf16_f32 v153, v153, v153
    ds_write_b16 v122, v153 offset:4096
    ds_write_b32 v7, v199 offset:3592
L_lhf:
    s_branch L_hb1
L_red:
    s_lshl_b32 s48, s2, 12
    s_add_u32 s48, s48, 262144
    v_add_u32 v126, s48, v5
    v_and_b32 v125, 3, v1
    v_lshl_add_u32 v125, v125, 2, v6
    s_lshl_b32 s48, s2, 4
    v_add_lshl_u32 v125, v125, s48, 1
    ds_read_u16 v160, v125 offset:5120
    s_mov_b32 s55, 0
    s_mov_b32 s35, 0
    s_waitcnt lgkmcnt(0)
    v_lshlrev_b32 v160, 16, v160
    s_branch L_fm2
L_redgo:
    s_mov_b32 s35, 1
    s_barrier
L_pf:
    global_load_dwordx4 v[48:51], v126, s[26:27] offset:2048 sc1
    v_mov_b32 v52, s37
    v_mov_b32 v53, s38
    v_mov_b32 v54, s39
    v_mov_b32 v55, s40
    s_mov_b32 exec_hi, 0x0000ffff
    global_load_dwordx4 v[52:55], v126, s[26:27] offset:3072 sc1
    s_mov_b32 exec_hi, -1
    s_add_u32 s55, s55, 1
    s_cmp_ge_u32 s55, 262144
    s_cbranch_scc1 L_fin
    global_load_dwordx4 v[56:59], v126, s[26:27] sc1
    global_load_dwordx4 v[60:63], v126, s[26:27] offset:1024 sc1
    s_waitcnt vmcnt(2)
    v_xor_b32 v48, s37, v48
    v_xor_b32 v49, s38, v49
    v_xor_b32 v50, s39, v50
    v_xor_b32 v51, s40, v51
    v_xor_b32 v52, s37, v52
    v_xor_b32 v53, s38, v53
    v_xor_b32 v54, s39, v54
    v_xor_b32 v55, s40, v55
    v_or3_b32 v122, v48, v49, v50
    v_or3_b32 v122, v122, v51, v52
    v_or3_b32 v122, v122, v53, v54
    v_or_b32 v122, v122, v55
    v_and_b32 v124, 0xff, v122
    v_cmp_ne_u32 vcc, 0, v124
    s_cbranch_vccnz L_pfr
    global_load_dwordx4 v[64:67], v126, s[26:27] sc1
    global_load_dwordx4 v[68:71], v126, s[26:27] offset:1024 sc1
    v_pk_add_f32 v[48:49], v[48:49], v[52:53]
    v_pk_add_f32 v[50:51], v[50:51], v[54:55]
    s_nop 1
    v_permlane32_swap_b32 v48, v50
    v_permlane32_swap_b32 v49, v51
    v_pk_add_f32 v[144:145], v[48:49], v[50:51]
    s_nop 0
    s_nop 0
    v_permlane16_swap_b32 v144, v145
    v_add_f32 v144, v144, v145
    s_nop 1
    v_add_f32_dpp v144, v144, v144 row_ror:4 row_mask:0xf bank_mask:0xf
    s_nop 1
    v_add_f32_dpp v144, v144, v144 row_ror:8 row_mask:0xf bank_mask:0xf
    v_cvt_pk_bf16_f32 v144, v144, v144
    v_lshlrev_b32 v144, 16, v144
    v_mul_f32 v145, s57, v144
    v_exp_f32 v145, -v145
    s_nop 0
    v_add_f32 v145, 1.0, v145
    v_rcp_f32 v145, v145
    s_nop 0
    v_mul_f32 v145, v144, v145
    v_cvt_pk_bf16_f32 v145, v145, v145
    v_lshlrev_b32 v161, 16, v145
L_ps:
    global_load_dwordx4 v[72:75], v126, s[26:27] sc1
    global_load_dwordx4 v[76:79], v126, s[26:27] offset:1024 sc1
    s_waitcnt vmcnt(4)
    v_xor_b32 v56, s37, v56
    v_xor_b32 v57, s38, v57
    v_xor_b32 v58, s39, v58
    v_xor_b32 v59, s40, v59
    v_xor_b32 v60, s37, v60
    v_xor_b32 v61, s38, v61
    v_xor_b32 v62, s39, v62
    v_xor_b32 v63, s40, v63
    v_or3_b32 v122, v56, v57, v58
    v_or3_b32 v122, v122, v59, v60
    v_or3_b32 v122, v122, v61, v62
    v_or_b32 v122, v122, v63
    v_and_b32 v124, 0xff, v122
    v_cmp_ne_u32 vcc, 0, v124
    s_cbranch_vccz L_fm0
    global_load_dwordx4 v[56:59], v126, s[26:27] sc1
    global_load_dwordx4 v[60:63], v126, s[26:27] offset:1024 sc1
    s_waitcnt vmcnt(4)
    v_xor_b32 v64, s37, v64
    v_xor_b32 v65, s38, v65
    v_xor_b32 v66, s39, v66
    v_xor_b32 v67, s40, v67
    v_xor_b32 v68, s37, v68
    v_xor_b32 v69, s38, v69
    v_xor_b32 v70, s39, v70
    v_xor_b32 v71, s40, v71
    v_or3_b32 v122, v64, v65, v66
    v_or3_b32 v122, v122, v67, v68
    v_or3_b32 v122, v122, v69, v70
    v_or_b32 v122, v122, v71
    v_and_b32 v124, 0xff, v122
    v_cmp_ne_u32 vcc, 0, v124
    s_cbranch_vccz L_fm1
    global_load_dwordx4 v[64:67], v126, s[26:27] sc1
    global_load_dwordx4 v[68:71], v126, s[26:27] offset:1024 sc1
    s_waitcnt vmcnt(4)
    v_xor_b32 v72, s37, v72
    v_xor_b32 v73, s38, v73
    v_xor_b32 v74, s39, v74
    v_xor_b32 v75, s40, v75
    v_xor_b32 v76, s37, v76
    v_xor_b32 v77, s38, v77
    v_xor_b32 v78, s39, v78
    v_xor_b32 v79, s40, v79
    v_or3_b32 v122, v72, v73, v74
    v_or3_b32 v122, v122, v75, v76
    v_or3_b32 v122, v122, v77, v78
    v_or_b32 v122, v122, v79
    v_and_b32 v124, 0xff, v122
    v_cmp_ne_u32 vcc, 0, v124
    s_cbranch_vccz L_fm2
    s_add_u32 s55, s55, 1
    s_cmp_lt_u32 s55, 262144
    s_cbranch_scc1 L_ps
    s_branch L_fin
L_pfr:
    s_waitcnt vmcnt(0)
    s_branch L_pf
L_fm0:
    v_pk_add_f32 v[56:57], v[56:57], v[60:61]
    v_pk_add_f32 v[58:59], v[58:59], v[62:63]
    s_nop 1
    v_permlane32_swap_b32 v56, v58
    v_permlane32_swap_b32 v57, v59
    v_pk_add_f32 v[144:145], v[56:57], v[58:59]
    s_branch L_fmr
L_fm1:
    v_pk_add_f32 v[64:65], v[64:65], v[68:69]
    v_pk_add_f32 v[66:67], v[66:67], v[70:71]
    s_nop 1
    v_permlane32_swap_b32 v64, v66
    v_permlane32_swap_b32 v65, v67
    v_pk_add_f32 v[144:145], v[64:65], v[66:67]
    s_branch L_fmr
L_fm2:
    v_pk_add_f32 v[72:73], v[72:73], v[76:77]
    v_pk_add_f32 v[74:75], v[74:75], v[78:79]
    s_nop 1
    v_permlane32_swap_b32 v72, v74
    v_permlane32_swap_b32 v73, v75
    v_pk_add_f32 v[144:145], v[72:73], v[74:75]
    s_nop 0
L_fmr:
    s_nop 0
    v_permlane16_swap_b32 v144, v145
    v_add_f32 v144, v144, v145
    s_nop 1
    v_add_f32_dpp v144, v144, v144 row_ror:4 row_mask:0xf bank_mask:0xf
    s_nop 1
    v_add_f32_dpp v144, v144, v144 row_ror:8 row_mask:0xf bank_mask:0xf
    v_cvt_pk_bf16_f32 v144, v144, v144
    v_lshlrev_b32 v144, 16, v144
    v_mul_f32 v144, v144, v161
    v_cvt_pk_bf16_f32 v144, v144, v144
    v_lshlrev_b32 v144, 16, v144
    v_add_f32 v144, v160, v144
    v_cvt_pk_bf16_f32 v144, v144, v144
    s_cmp_eq_u32 s35, 0
    s_cbranch_scc1 L_redgo
    s_mov_b32 exec_lo, 0x000f000f
    s_mov_b32 exec_hi, 0x000f000f
    global_store_short v125, v144, s[22:23]
    s_cmp_lg_u32 s2, 0
    s_cbranch_scc1 L_fin
    s_mov_b64 exec, 1
    v_mov_b32 v150, s36
    global_store_dword v7, v150, s[26:27]
    s_branch L_fin
L_hlate:
    ds_read_b32 v127, v7 offset:3592
    s_waitcnt lgkmcnt(0)
    v_cmp_eq_u32 vcc, 0, v127
    s_cbranch_vccnz L_hlate
    v_cmp_eq_u32 vcc, 1, v127
    s_cbranch_vccnz L_hl2
    s_lshl_b32 s48, s28, 13
    s_add_u32 s48, s48, 65536
    s_lshl_b32 s49, s32, 9
    s_add_u32 s49, s49, 65536
    s_cmp_lg_u32 s63, 0
    s_cselect_b32 s49, 0, s49
    s_add_u32 s49, s49, s48
    v_and_b32 v121, 31, v1
    v_lshrrev_b32 v123, 5, v1
    v_lshlrev_b32 v124, 12, v123
    v_lshl_add_u32 v124, v121, 4, v124
    v_add_u32 v191, s49, v124
    v_lshlrev_b32 v123, 2, v123
    v_lshl_add_u32 v196, v121, 3, v123
    s_mov_b64 vcc, -1
    s_branch L_slowg
L_okg:
    v_pk_add_f32 v[200:201], v[200:201], v[204:205]
    v_pk_add_f32 v[202:203], v[202:203], v[206:207]
    v_lshlrev_b32 v122, 1, v1
    s_nop 0
    v_permlane32_swap_b32 v200, v202
    v_permlane32_swap_b32 v201, v203
    v_pk_add_f32 v[200:201], v[200:201], v[202:203]
    v_cvt_pk_bf16_f32 v200, v200, v201
    ds_write_b32 v196, v200 offset:6144
    ds_read_u16 v153, v122 offset:6144
    ds_read_u16 v154, v122 offset:6272
    s_waitcnt lgkmcnt(0)
    v_lshlrev_b32 v153, 16, v153
    v_mul_f32 v155, s57, v153
    v_exp_f32 v155, -v155
    v_lshlrev_b32 v154, 16, v154
    v_add_f32 v155, 1.0, v155
    v_rcp_f32 v155, v155
    s_nop 0
    v_mul_f32 v153, v153, v155
    v_cvt_pk_bf16_f32 v153, v153, v153
    v_lshlrev_b32 v153, 16, v153
    v_mul_f32 v153, v153, v154
    v_cvt_pk_bf16_f32 v153, v153, v153
    ds_write_b16 v122, v153 offset:4096
L_hl2:
L_fl10:
    ds_read_b32 v127, v7 offset:3596
    s_waitcnt lgkmcnt(0)
    v_cmp_gt_u32 vcc, 24, v127
    s_cbranch_vccnz L_fl10
    ds_read_b128 v[16:19], v15 offset:4096
    ds_read_b128 v[20:23], v15 offset:4160
    ds_read_b64_tr_b16 v[208:209], v13 offset:8192
    ds_read_b64_tr_b16 v[210:211], v13 offset:10240
    ds_read_b64_tr_b16 v[212:213], v13 offset:12288
    ds_read_b64_tr_b16 v[214:215], v13 offset:14336
    s_waitcnt lgkmcnt(2)
    v_mfma_f32_16x16x32_bf16 v[136:139], v[208:211], v[16:19], 0
    s_waitcnt lgkmcnt(0)
    v_mfma_f32_16x16x32_bf16 v[136:139], v[212:215], v[20:23], v[136:139]
    s_nop 4
    s_mov_b32 exec_lo, 0x00010001
    s_mov_b32 exec_hi, 0x00010001
    s_mov_b32 s55, 0
    v_and_or_b32 v152, v136, v128, s37
    v_and_or_b32 v153, v137, v128, s38
    v_and_or_b32 v154, v138, v128, s39
    v_and_or_b32 v155, v139, v128, s40
    global_store_dwordx4 v198, v[152:155], s[26:27] sc1
    s_mov_b64 exec, -1
    s_branch L_hret
L_lre:
    global_load_dwordx4 v[200:203], v191, s[26:27] offset:0 sc1
    global_load_dwordx4 v[204:207], v191, s[26:27] offset:2048 sc1
    s_branch L_lhf
L_lh2:
    v_xor_b32 v200, s37, v200
    v_xor_b32 v201, s38, v201
    v_xor_b32 v202, s39, v202
    v_xor_b32 v203, s40, v203
    v_xor_b32 v204, s37, v204
    v_xor_b32 v205, s38, v205
    v_xor_b32 v206, s39, v206
    v_xor_b32 v207, s40, v207
    v_and_b32 v200, -8, v200
    v_and_b32 v204, -8, v204
    v_or3_b32 v122, v200, v201, v202
    v_or3_b32 v122, v122, v203, v204
    v_or3_b32 v122, v122, v205, v206
    v_or_b32 v122, v122, v207
    v_and_b32 v124, 0xff, v122
    v_cmp_ne_u32 vcc, 0, v124
    v_mov_b32 v41, 2
    s_cbranch_vccnz L_lh2f
    v_pk_add_f32 v[200:201], v[200:201], v[204:205]
    v_pk_add_f32 v[202:203], v[202:203], v[206:207]
    v_lshlrev_b32 v122, 1, v1
    s_nop 0
    v_permlane32_swap_b32 v200, v202
    v_permlane32_swap_b32 v201, v203
    v_pk_add_f32 v[200:201], v[200:201], v[202:203]
    v_cvt_pk_bf16_f32 v200, v200, v201
    ds_write_b32 v196, v200 offset:6144
    ds_read_u16 v153, v122 offset:6144
    ds_read_u16 v154, v122 offset:6272
    s_waitcnt lgkmcnt(0)
    v_lshlrev_b32 v153, 16, v153
    v_mul_f32 v155, s57, v153
    v_exp_f32 v155, -v155
    v_lshlrev_b32 v154, 16, v154
    v_add_f32 v155, 1.0, v155
    v_rcp_f32 v155, v155
    s_nop 0
    v_mul_f32 v153, v153, v155
    v_cvt_pk_bf16_f32 v153, v153, v153
    v_lshlrev_b32 v153, 16, v153
    v_mul_f32 v153, v153, v154
    v_cvt_pk_bf16_f32 v153, v153, v153
    ds_write_b16 v122, v153 offset:4096
    v_mov_b32 v41, 1
L_lh2f:
    ds_write_b32 v7, v41 offset:3592
    s_branch L_lh2r
L_ppr:
    s_add_u32 s55, s55, 1
    s_cmp_ge_u32 s55, 262144
    s_cbranch_scc1 L_ppok
    s_waitcnt lgkmcnt(0)
    s_branch L_pp
L_slowg:
    s_mov_b64 exec, vcc
    s_add_u32 s55, s55, 1
    s_cmp_ge_u32 s55, 262144
    s_cbranch_scc1 L_doneg
    global_load_dwordx4 v[200:203], v191, s[26:27] offset:0 sc1
    global_load_dwordx4 v[204:207], v191, s[26:27] offset:2048 sc1
    v_xor_b32 v191, 1048576, v191
    s_waitcnt vmcnt(0)
    v_xor_b32 v200, s41, v200
    v_xor_b32 v201, s38, v201
    v_xor_b32 v202, s39, v202
    v_xor_b32 v203, s40, v203
    v_xor_b32 v204, s41, v204
    v_xor_b32 v205, s38, v205
    v_xor_b32 v206, s39, v206
    v_xor_b32 v207, s40, v207
    v_and_b32 v200, -8, v200
    v_and_b32 v204, -8, v204
    v_or3_b32 v122, v200, v201, v202
    v_or3_b32 v122, v122, v203, v204
    v_or3_b32 v122, v122, v205, v206
    v_or_b32 v122, v122, v207
    v_and_b32 v124, 0xff, v122
    v_cmp_ne_u32 vcc, 0, v124
    s_cbranch_vccnz L_slowg
L_doneg:
    s_mov_b64 exec, -1
    s_branch L_okg
L_pub2_far:
    v_add_u32 v182, 4194304, v182
    global_store_dwordx4 v182, v[132:135], s[26:27] sc1
    s_mov_b64 exec, 15
    v_or_b32 v148, s37, v148
    v_or_b32 v149, s38, v149
    v_mov_b32 v150, s39
    v_mov_b32 v151, s40
    s_lshl_b32 s48, s62, 1
    s_add_u32 s48, s48, 3801088
    v_lshl_add_u32 v183, v183, 1, s48
    s_waitcnt vmcnt(0)
    global_store_dwordx4 v183, v[148:151], s[26:27] sc1
    s_branch L_pub2_done
L_far_get:
    v_add_u32 v184, 4194304, v184
    s_lshl_b32 s48, s62, 1
    s_add_u32 s48, s48, 3801088
    v_lshl_add_u32 v185, v185, 1, s48
    s_waitcnt vmcnt(0) lgkmcnt(0)
L_far_loop:
    s_add_u32 s55, s55, 1
    s_cmp_ge_u32 s55, 262144
    s_cbranch_scc1 L_done2
    global_load_dwordx4 v[52:55], v185, s[26:27] sc1
    s_waitcnt vmcnt(0)
    v_xor_b32 v52, s37, v52
    v_xor_b32 v53, s38, v53
    v_xor_b32 v54, s39, v54
    v_xor_b32 v55, s40, v55
    v_or3_b32 v122, v52, v53, v54
    v_or_b32 v122, v122, v55
    v_and_b32 v124, 0xff, v122
    v_cmp_ne_u32 vcc, 0, v124
    s_cbranch_vccnz L_far_loop
    global_load_dwordx4 v[160:163], v184, s[26:27] offset:0 sc1
    global_load_dwordx4 v[164:167], v184, s[26:27] offset:512 sc1
    global_load_dwordx4 v[168:171], v184, s[26:27] offset:1024 sc1
    global_load_dwordx4 v[172:175], v184, s[26:27] offset:1536 sc1
    s_waitcnt vmcnt(0)
    s_branch L_chk2
s_endpgm
.section .rodata,"a"
.p2align 6
.amdhsa_kernel recurrent_scan__sliding_block_cached__swiglu_ffn__decode_kernel
  .amdhsa_next_free_vgpr 252
  .amdhsa_next_free_sgpr 102
  .amdhsa_accum_offset 252
  .amdhsa_group_segment_fixed_size 0
  .amdhsa_kernarg_size 96
  .amdhsa_user_sgpr_count 2
  .amdhsa_user_sgpr_kernarg_segment_ptr 1
  .amdhsa_system_sgpr_workgroup_id_x 1
  .amdhsa_float_denorm_mode_32 3
.end_amdhsa_kernel
```
